```python
import torch

def _softmax(x, axis=-1):
    return torch.softmax(x, dim=axis)
def _gelu(x):
    return torch.nn.functional.gelu(x, approximate="tanh")
def _silu(x):
    return torch.nn.functional.silu(x)
def _sigmoid(x):
    return torch.sigmoid(x)
def _layernorm(x, axis=-1, eps=1e-5):
    m = x.mean(dim=axis, keepdim=True)
    v = x.var(dim=axis, keepdim=True, unbiased=False)
    return (x - m) / torch.sqrt(v + eps)
def _scatter_add(tgt, idx, src, axis=0):
    return tgt.clone().index_add_(axis, idx, src)
def _segment_sum(src, seg, n):
    out = torch.zeros((n,) + src.shape[1:], dtype=src.dtype)
    return out.index_add_(0, seg, src)
def _pad(x, pw):
    flat = tuple(v for pair in reversed(pw) for v in pair)
    return torch.nn.functional.pad(x, flat)

kernel_name = 'standalone__instancenorm__prompt'

def setup_inputs():

    _w = (lambda a: (lambda t: t.to(torch.bfloat16) if t.is_floating_point() else t)(torch.as_tensor(a)))
    B, C, H, W = 1, 576, 2048, 32
    return {
        "x": _w(abs((lambda *s: torch.randn(*s, dtype=torch.bfloat16) * 0.05)(B, C, H, W))),
        "g": _w((lambda *s: torch.randn(*s, dtype=torch.bfloat16) * 0.05)(C) + 1.0),
        "b": _w((lambda *s: torch.randn(*s, dtype=torch.bfloat16) * 0.4)(C)),
    }

def reference(x, g, b):
    mu = x.mean(axis=(-2, -1), keepdims=True)
    var = ((x - mu) ** 2).mean(axis=(-2, -1), keepdims=True)
    xhat = (x - mu) / torch.sqrt(var + 1e-5)
    return xhat * g.reshape(1, -1, 1, 1) + b.reshape(1, -1, 1, 1)
```

```asm
; @launch grid=(256,1,1) block=(1024,1,1) lds=816
.amdgcn_target "amdgcn-amd-amdhsa--gfx950"
.text
.globl standalone__instancenorm__prompt_kernel
.p2align 8
.type standalone__instancenorm__prompt_kernel,@function
standalone__instancenorm__prompt_kernel:
    s_load_dwordx8 s[4:11], s[0:1], 0
    s_load_dwordx2 s[12:13], s[0:1], 40
    s_cmp_ge_u32 s2, 256
    s_cbranch_scc1 L_end
    v_readfirstlane_b32 s15, v0
    s_lshr_b32 s54, s2, 3
    s_and_b32 s55, s2, 3
    s_bfe_u32 s14, s2, 0x10002
    s_lshl_b32 s3, s54, 2
    s_or_b32 s3, s3, s55
    s_lshr_b32 s42, s3, 1
    s_and_b32 s43, s3, 1
    s_lshl_b32 s44, s43, 1
    s_or_b32 s44, s44, s14
    s_lshr_b32 s15, s15, 6
    v_lshlrev_b32 v2, 4, v0
    v_and_b32 v1, 0x1fff, v2
    v_lshrrev_b32 v4, 9, v0
    v_lshl_add_u32 v1, v4, 14, v1
    v_bfe_u32 v3, v0, 5, 5
    v_lshlrev_b32 v3, 2, v3
    v_mov_b32 v97, 0
    s_lshl_b32 s24, s42, 2
    s_add_u32 s24, s24, s44
    s_lshl_b32 s24, s24, 15
    s_add_u32 s24, s24, 67108864
    s_add_u32 s25, s24, 16384
    s_lshl_b32 s26, s3, 19
    s_add_u32 s27, s26, 32768
    s_add_u32 s28, s26, 65536
    s_add_u32 s29, s26, 98304
    s_add_u32 s30, s26, 131072
    s_add_u32 s31, s26, 163840
    s_add_u32 s32, s26, 196608
    s_add_u32 s33, s26, 229376
    s_add_u32 s34, s26, 262144
    s_add_u32 s35, s26, 294912
    s_add_u32 s36, s26, 327680
    s_add_u32 s37, s26, 360448
    s_add_u32 s38, s26, 393216
    s_add_u32 s39, s26, 425984
    s_add_u32 s40, s26, 458752
    s_add_u32 s41, s26, 491520
    s_lshl_b32 s46, s54, 12
    s_lshr_b32 s61, s55, 1
    s_lshl_b32 s61, s61, 7
    s_lshl_b32 s64, s44, 4
    s_add_u32 s64, s64, s61
    s_lshl_b32 s47, s55, 9
    s_lshl_b32 s57, s14, 4
    s_add_u32 s57, s57, s47
    s_xor_b32 s65, s57, 16
    s_mov_b32 s18, 75497472
    s_mov_b32 s19, 0x20000
    s_mov_b32 s22, 75497472
    s_mov_b32 s23, 0x20000
    s_mov_b32 s67, 0x3f803f80
    s_mov_b32 s68, 0
    s_lshl_b32 s62, s55, 2
    s_add_u32 s62, s62, s54
    s_and_b32 s62, s62, 15
    s_lshl_b32 s62, s62, 8
    s_lshl_b32 s63, s14, 12
    s_add_u32 s62, s62, s63
    s_bfe_u32 s63, s54, 0x10004
    s_lshl_b32 s63, s63, 14
    s_add_u32 s62, s62, s63
    s_add_u32 s62, s62, s26
    s_add_u32 s62, s62, 491520
    s_add_u32 s63, s62, 8192
    s_getreg_b32 s58, hwreg(HW_REG_XCC_ID, 2, 1)
    s_and_b32 s48, s2, 7
    s_lshl_b32 s48, s48, 3
    s_mov_b32 s70, 0
    s_getpc_b64 s[92:93]
L_pc:
    v_lshlrev_b32 v10, 7, v0
    v_min_u32 v10, L_end - L_pc, v10
    s_waitcnt lgkmcnt(0)
    s_mov_b32 s16, s4
    s_mov_b32 s17, s5
    s_add_u32 s12, s12, s46
    s_addc_u32 s13, s13, 0
    s_and_b32 s75, s10, 0x3ff0
    s_andn2_b32 s74, s62, 0x4000
    s_add_u32 s74, s74, 0x4000
    s_sub_u32 s74, s74, s75
    s_cmp_eq_u32 s43, 0
    s_cselect_b32 s62, s62, s74
    s_mov_b32 s20, s10
    s_mov_b32 s21, s11
    s_add_u32 s63, s62, 8192
    s_cmp_lg_u32 s15, 0
    s_cbranch_scc1 L_cast
    s_load_dword s50, s[12:13], 192
    s_mov_b64 exec, 1
    s_cmp_eq_u32 s43, 0
    s_cbranch_scc1 L_probe
    s_branch L_sprobe
    .p2align 6
L_sprobe:
    buffer_store_dword v97, v97, s[20:23], s62 offen sc0 sc1
    buffer_store_dword v97, v97, s[20:23], s63 offen sc0 sc1
L_swatch:
    s_getreg_b32 s59, hwreg(HW_REG_IB_STS, 0, 4)
    s_cmp_eq_u32 s59, 1
    s_addc_u32 s70, s70, 0
    s_cmp_gt_u32 s59, 0
    s_cbranch_scc1 L_swatch
    s_min_u32 s70, s70, 4
    s_branch L_seen
    .p2align 6
L_probe:
    buffer_load_dword v8, v97, s[16:19], s62 offen nt
    buffer_load_dword v9, v97, s[16:19], s63 offen nt
L_watch:
    s_getreg_b32 s59, hwreg(HW_REG_IB_STS, 0, 4)
    s_cmp_eq_u32 s59, 1
    s_addc_u32 s70, s70, 0
    s_cmp_le_u32 s70, 3
    s_cselect_b32 s59, s59, 0
    s_cmp_gt_u32 s59, 0
    s_cbranch_scc1 L_watch
L_seen:
    s_max_u32 s70, s70, 1
    s_sub_u32 s70, s70, 1
    s_lshl_b32 s70, s70, 8
    s_sub_u32 s59, 1, s70
    s_cmp_eq_u32 s58, 0
    s_cselect_b32 s70, s70, s59
    s_waitcnt lgkmcnt(0)
    s_mul_i32 s71, s50, 0x9e3779b1
    s_add_u32 s71, s71, 0x7f4a7c15
    v_mov_b32 v14, s70
    v_mov_b32 v15, s71
    v_mov_b32 v12, s48
    s_mov_b64 exec, 1
    global_store_dwordx2 v12, v[14:15], s[12:13] offset:128 sc0 sc1
    s_mov_b64 exec, -1
    global_load_dword v100, v10, s[92:93]
L_cast:
    s_mov_b64 exec, -1
    s_barrier
L_go:
    buffer_load_dwordx4 v[16:19], v2, s[16:19], s24 offen nt
    buffer_load_dwordx4 v[20:23], v2, s[16:19], s25 offen nt
    s_cmp_lg_u32 s15, 0
    s_cbranch_scc1 L_w11
L_pp3:
    s_add_u32 s68, s68, 1
    s_cmp_gt_u32 s68, 1000000
    s_cbranch_scc1 L_pd4
    s_load_dwordx16 s[76:91], s[12:13], 128 glc
    s_waitcnt lgkmcnt(0)
    s_cmp_lg_u32 s77, s71
    s_cbranch_scc1 L_pp3
    s_cmp_lg_u32 s79, s71
    s_cbranch_scc1 L_pp3
    s_cmp_lg_u32 s81, s71
    s_cbranch_scc1 L_pp3
    s_cmp_lg_u32 s83, s71
    s_cbranch_scc1 L_pp3
    s_cmp_lg_u32 s85, s71
    s_cbranch_scc1 L_pp3
    s_cmp_lg_u32 s87, s71
    s_cbranch_scc1 L_pp3
    s_cmp_lg_u32 s89, s71
    s_cbranch_scc1 L_pp3
    s_cmp_lg_u32 s91, s71
    s_cbranch_scc1 L_pp3
L_pd4:
    s_add_u32 s60, s76, s80
    s_add_u32 s74, s78, s82
    s_add_u32 s60, s60, s84
    s_add_u32 s74, s74, s86
    s_add_u32 s60, s60, s88
    s_add_u32 s74, s74, s90
    s_xor_b32 s74, s74, s60
    s_lshr_b32 s74, s74, 30
    s_and_b32 s74, s74, 2
    s_lshr_b32 s60, s60, 31
    s_cmp_eq_u32 s55, 1
    s_cselect_b32 s62, s78, s76
    s_cmp_eq_u32 s55, 2
    s_cselect_b32 s62, s80, s62
    s_cmp_eq_u32 s55, 3
    s_cselect_b32 s62, s82, s62
    s_xor_b32 s69, s60, s62
    s_xor_b32 s69, s69, s14
    s_and_b32 s69, s69, 1
    s_or_b32 s69, s69, s74
    v_mov_b32 v10, s69
    v_mov_b32 v11, s71
    s_mov_b64 exec, 1
    ds_write_b64 v97, v[10:11] offset:800
    s_mov_b64 exec, -1
    s_waitcnt lgkmcnt(0)
    s_branch L_ab2
L_w11:
    s_cmp_lg_u32 s15, 1
    s_cbranch_scc1 L_ab2
    v_and_b32 v7, 63, v0
    v_mov_b32 v8, 0
    v_mov_b32 v9, 0
    v_mov_b32 v10, 0
    s_lshl_b32 s48, s3, 2
    v_add_u32 v12, s48, v7
    s_add_u32 s48, s42, 512
    v_writelane_b32 v12, s48, 4
    s_mov_b64 exec, 0x1f
    v_lshlrev_b32 v13, 17, v12
    v_lshlrev_b32 v12, 1, v12
    v_lshlrev_b32 v7, 4, v7
    global_load_short_d16_hi v8, v13, s[4:5]
    global_load_short_d16_hi v9, v12, s[6:7]
    global_load_short_d16_hi v10, v12, s[8:9]
    v_lshlrev_b32 v13, 3, v7
    v_add_u32 v13, s47, v13
    v_add_u32 v13, 0x100, v13
    v_writelane_b32 v13, s61, 4
    global_load_dword v100, v13, s[12:13] offset:256
    s_mov_b64 exec, -1
L_ab2:
    s_barrier
    ds_read_b64 v[4:5], v97 offset:800
    s_waitcnt lgkmcnt(0)
    v_lshrrev_b32 v6, 1, v4
    v_and_b32 v4, 1, v4
    v_xor_b32 v6, v6, v4
    v_lshl_add_u32 v101, v6, 13, v1
    s_and_b32 s75, s10, 0x3ff0
    v_subrev_u32 v101, s75, v101
    v_and_b32 v101, 0x7fff, v101
    v_lshl_add_u32 v1, v4, 13, v1
    v_readfirstlane_b32 s51, v5
    buffer_load_dwordx4 v[24:27], v101, s[16:19], s26 offen nt
    s_cmp_lg_u32 s15, 1
    s_cbranch_scc1 L_gw5
    s_waitcnt vmcnt(2)
    s_mov_b64 exec, 0x1f
    ds_write_b96 v7, v[8:10] offset:720
    s_mov_b64 exec, -1
    s_waitcnt lgkmcnt(0)
L_gw5:
    s_barrier
    ds_read_b32 v88, v97 offset:720
    ds_read_b32 v89, v97 offset:736
    ds_read_b32 v90, v97 offset:752
    ds_read_b32 v91, v97 offset:768
    ds_read_b32 v92, v97 offset:784
    s_waitcnt vmcnt(2)
    v_dot2_f32_bf16 v4, v16, s67, 0
    v_dot2_f32_bf16 v6, v16, v16, 0
    v_dot2_f32_bf16 v5, v17, s67, 0
    v_dot2_f32_bf16 v7, v17, v17, 0
    s_nop 1
    v_dot2c_f32_bf16 v4, s67, v18
    v_dot2c_f32_bf16 v6, v18, v18
    v_dot2c_f32_bf16 v5, s67, v19
    v_dot2c_f32_bf16 v7, v19, v19
    buffer_load_dwordx4 v[28:31], v101, s[16:19], s27 offen nt
    s_waitcnt vmcnt(2)
    v_dot2c_f32_bf16 v4, s67, v20
    v_dot2c_f32_bf16 v6, v20, v20
    v_dot2c_f32_bf16 v5, s67, v21
    v_dot2c_f32_bf16 v7, v21, v21
    v_dot2c_f32_bf16 v4, s67, v22
    v_dot2c_f32_bf16 v6, v22, v22
    v_dot2c_f32_bf16 v5, s67, v23
    v_dot2c_f32_bf16 v7, v23, v23
    s_waitcnt lgkmcnt(0)
    s_nop 1
    v_add_f32 v4, v4, v5
    v_add_f32 v6, v6, v7
    v_mul_f32 v5, 0x3d800000, v4
    v_fma_f32 v6, -v4, v5, v6
    v_sub_f32 v4, v5, v92
    v_mul_f32 v5, 0x41800000, v4
    v_fma_f32 v5, v5, v4, v6
    s_nop 1
    v_permlane32_swap_b32 v4, v5
    s_nop 1
    v_add_f32 v4, v4, v5
    s_nop 1
    v_add_f32_dpp v4, v4, v4 quad_perm:[1,0,3,2] row_mask:0xf bank_mask:0xf
    s_nop 1
    v_add_f32_dpp v4, v4, v4 quad_perm:[2,3,0,1] row_mask:0xf bank_mask:0xf
    s_nop 1
    v_add_f32_dpp v4, v4, v4 row_half_mirror row_mask:0xf bank_mask:0xf
    s_nop 1
    v_add_f32_dpp v4, v4, v4 row_mirror row_mask:0xf bank_mask:0xf
    s_nop 1
    v_add_f32_dpp v4, v4, v4 row_bcast:15 row_mask:0xa bank_mask:0xf
    s_mov_b32 exec_lo, 0x80000000
    s_mov_b32 exec_hi, 0x80000000
    ds_write_b32 v3, v4 offset:0
    s_mov_b64 exec, -1
    buffer_load_dwordx4 v[32:35], v101, s[16:19], s28 offen nt
    s_waitcnt lgkmcnt(0)
    s_barrier
    s_waitcnt vmcnt(2)
    v_dot2_f32_bf16 v4, v24, s67, 0
    v_dot2_f32_bf16 v6, v24, v24, 0
    v_dot2_f32_bf16 v5, v25, s67, 0
    v_dot2_f32_bf16 v7, v25, v25, 0
    s_nop 1
    v_dot2c_f32_bf16 v4, s67, v26
    v_dot2c_f32_bf16 v6, v26, v26
    v_dot2c_f32_bf16 v5, s67, v27
    v_dot2c_f32_bf16 v7, v27, v27
    buffer_load_dwordx4 v[36:39], v101, s[16:19], s29 offen nt
    s_waitcnt vmcnt(2)
    v_dot2c_f32_bf16 v4, s67, v28
    v_dot2c_f32_bf16 v6, v28, v28
    v_dot2c_f32_bf16 v5, s67, v29
    v_dot2c_f32_bf16 v7, v29, v29
    v_dot2c_f32_bf16 v4, s67, v30
    v_dot2c_f32_bf16 v6, v30, v30
    v_dot2c_f32_bf16 v5, s67, v31
    v_dot2c_f32_bf16 v7, v31, v31
    buffer_load_dwordx4 v[40:43], v101, s[16:19], s30 offen nt
    s_waitcnt vmcnt(2)
    v_dot2c_f32_bf16 v4, s67, v32
    v_dot2c_f32_bf16 v6, v32, v32
    v_dot2c_f32_bf16 v5, s67, v33
    v_dot2c_f32_bf16 v7, v33, v33
    v_dot2c_f32_bf16 v4, s67, v34
    v_dot2c_f32_bf16 v6, v34, v34
    v_dot2c_f32_bf16 v5, s67, v35
    v_dot2c_f32_bf16 v7, v35, v35
    buffer_load_dwordx4 v[44:47], v101, s[16:19], s31 offen nt
    s_waitcnt vmcnt(2)
    v_dot2c_f32_bf16 v4, s67, v36
    v_dot2c_f32_bf16 v6, v36, v36
    v_dot2c_f32_bf16 v5, s67, v37
    v_dot2c_f32_bf16 v7, v37, v37
    v_dot2c_f32_bf16 v4, s67, v38
    v_dot2c_f32_bf16 v6, v38, v38
    v_dot2c_f32_bf16 v5, s67, v39
    v_dot2c_f32_bf16 v7, v39, v39
    s_nop 2
    v_add_f32 v4, v4, v5
    v_add_f32 v6, v6, v7
    v_mul_f32 v5, 0x3d000000, v4
    v_fma_f32 v6, -v4, v5, v6
    v_sub_f32 v4, v5, v88
    v_mul_f32 v5, 0x42000000, v4
    v_fma_f32 v5, v5, v4, v6
    s_nop 1
    v_permlane32_swap_b32 v4, v5
    s_nop 1
    v_add_f32 v4, v4, v5
    s_nop 1
    v_add_f32_dpp v4, v4, v4 quad_perm:[1,0,3,2] row_mask:0xf bank_mask:0xf
    s_nop 1
    v_add_f32_dpp v4, v4, v4 quad_perm:[2,3,0,1] row_mask:0xf bank_mask:0xf
    s_nop 1
    v_add_f32_dpp v4, v4, v4 row_half_mirror row_mask:0xf bank_mask:0xf
    s_nop 1
    v_add_f32_dpp v4, v4, v4 row_mirror row_mask:0xf bank_mask:0xf
    s_nop 1
    v_add_f32_dpp v4, v4, v4 row_bcast:15 row_mask:0xa bank_mask:0xf
    s_mov_b32 exec_lo, 0x80000000
    s_mov_b32 exec_hi, 0x80000000
    ds_write_b32 v3, v4 offset:128
    s_mov_b64 exec, -1
    buffer_load_dwordx4 v[48:51], v101, s[16:19], s32 offen nt
    s_cmp_lg_u32 s15, 0
    s_cbranch_scc1 L_nl6
    s_mov_b32 s93, s51
    s_mov_b32 s95, s51
    v_and_b32 v94, 15, v0
    v_bfe_u32 v95, v0, 4, 1
    v_lshlrev_b32 v94, 3, v94
    v_lshl_add_u32 v94, v95, 2, v94
    ds_read_b32 v94, v94 offset:0
    s_waitcnt lgkmcnt(0)
    v_add_f32_dpp v94, v94, v94 quad_perm:[1,0,3,2] row_mask:0xf bank_mask:0xf
    s_nop 1
    v_add_f32_dpp v94, v94, v94 quad_perm:[2,3,0,1] row_mask:0xf bank_mask:0xf
    s_nop 1
    v_add_f32_dpp v94, v94, v94 row_half_mirror row_mask:0xf bank_mask:0xf
    s_nop 1
    v_add_f32_dpp v94, v94, v94 row_mirror row_mask:0xf bank_mask:0xf
    s_nop 1
    v_readlane_b32 s94, v94, 16
    v_mov_b32 v12, v94
    v_mov_b32 v13, s93
    v_mov_b32 v15, s95
    v_mov_b32 v95, s64
    v_mov_b32 v14, s94
    s_mov_b64 exec, 1
    global_store_dwordx4 v95, v[12:15], s[12:13] offset:256 sc0 sc1
    s_mov_b64 exec, -1
    s_nop 0
L_nl6:
    s_waitcnt lgkmcnt(0)
    s_barrier
    s_cmp_lg_u32 s15, 1
    s_cbranch_scc1 L_pi7
    s_load_dwordx16 s[76:91], s[12:13], s61 offset:256 glc
L_pi7:
    s_waitcnt vmcnt(2)
    v_dot2_f32_bf16 v4, v40, s67, 0
    v_dot2_f32_bf16 v6, v40, v40, 0
    v_dot2_f32_bf16 v5, v41, s67, 0
    v_dot2_f32_bf16 v7, v41, v41, 0
    s_nop 1
    v_dot2c_f32_bf16 v4, s67, v42
    v_dot2c_f32_bf16 v6, v42, v42
    v_dot2c_f32_bf16 v5, s67, v43
    v_dot2c_f32_bf16 v7, v43, v43
    buffer_load_dwordx4 v[52:55], v101, s[16:19], s33 offen nt
    s_cmp_lg_u32 s15, 2
    s_cbranch_scc1 L_nl8
    s_mov_b32 s93, s51
    s_mov_b32 s95, s51
    v_and_b32 v94, 15, v0
    v_bfe_u32 v95, v0, 4, 1
    v_lshlrev_b32 v94, 3, v94
    v_lshl_add_u32 v94, v95, 2, v94
    ds_read_b32 v94, v94 offset:128
    s_waitcnt lgkmcnt(0)
    v_add_f32_dpp v94, v94, v94 quad_perm:[1,0,3,2] row_mask:0xf bank_mask:0xf
    s_nop 1
    v_add_f32_dpp v94, v94, v94 quad_perm:[2,3,0,1] row_mask:0xf bank_mask:0xf
    s_nop 1
    v_add_f32_dpp v94, v94, v94 row_half_mirror row_mask:0xf bank_mask:0xf
    s_nop 1
    v_add_f32_dpp v94, v94, v94 row_mirror row_mask:0xf bank_mask:0xf
    s_nop 1
    v_readlane_b32 s94, v94, 16
    v_mov_b32 v12, v94
    v_mov_b32 v13, s93
    v_mov_b32 v15, s95
    v_mov_b32 v95, s57
    v_mov_b32 v14, s94
    s_mov_b64 exec, 1
    global_store_dwordx4 v95, v[12:15], s[12:13] offset:512 sc0 sc1
    s_mov_b64 exec, -1
    s_nop 0
L_nl8:
    s_cmp_lg_u32 s15, 1
    s_cbranch_scc1 L_go9
    ds_read_b32 v98, v97 offset:788
    ds_read_b32 v99, v97 offset:792
    s_branch L_ck12
L_cp10:
    s_add_u32 s68, s68, 1
    s_cmp_gt_u32 s68, 1000000
    s_cbranch_scc1 L_cd11
    s_load_dwordx16 s[76:91], s[12:13], s61 offset:256 glc
L_ck12:
    s_waitcnt lgkmcnt(0)
    s_cmp_lg_u32 s77, s51
    s_cbranch_scc1 L_cp10
    s_cmp_lg_u32 s79, s51
    s_cbranch_scc1 L_cp10
    s_cmp_lg_u32 s81, s51
    s_cbranch_scc1 L_cp10
    s_cmp_lg_u32 s83, s51
    s_cbranch_scc1 L_cp10
    s_cmp_lg_u32 s85, s51
    s_cbranch_scc1 L_cp10
    s_cmp_lg_u32 s87, s51
    s_cbranch_scc1 L_cp10
    s_cmp_lg_u32 s89, s51
    s_cbranch_scc1 L_cp10
    s_cmp_lg_u32 s91, s51
    s_cbranch_scc1 L_cp10
L_cd11:
    v_mov_b32 v94, s76
    v_mov_b32 v95, s78
    v_mov_b32 v8, s84
    v_mov_b32 v9, s86
    v_add_f32 v94, s80, v94
    v_add_f32 v95, s82, v95
    v_add_f32 v8, s88, v8
    v_add_f32 v9, s90, v9
    v_add_f32 v94, v94, v8
    v_add_f32 v95, v95, v9
    v_mul_f32 v94, 0x39800000, v94
    v_mul_f32 v95, 0x37800000, v95
    v_fma_f32 v95, -v94, v94, v95
    v_max_f32 v95, 0, v95
    v_add_f32 v94, v92, v94
    v_cvt_pk_bf16_f32 v8, v94, v94
    v_and_b32 v8, 0xffff0000, v8
    v_sub_f32 v94, v94, v8
    v_fma_f32 v95, v94, v94, v95
    v_cvt_pk_bf16_f32 v95, v95, v95
    v_and_b32 v95, 0xffff0000, v95
    v_add_f32 v95, 0x3727c5ac, v95
    v_cvt_pk_bf16_f32 v95, v95, v95
    v_and_b32 v95, 0xffff0000, v95
    v_sqrt_f32 v95, v95
    s_nop 0
    v_cvt_pk_bf16_f32 v95, v95, v95
    v_and_b32 v95, 0xffff0000, v95
    v_rcp_f32 v95, v95
    s_nop 0
    v_mul_f32 v94, v98, v95
    v_fma_f32 v95, -v8, v94, v99
    s_mov_b64 exec, 1
    ds_write_b64 v97, v[94:95] offset:640
    s_mov_b64 exec, -1
    s_waitcnt lgkmcnt(0)
L_go9:
    s_waitcnt vmcnt(2)
    v_dot2c_f32_bf16 v4, s67, v44
    v_dot2c_f32_bf16 v6, v44, v44
    v_dot2c_f32_bf16 v5, s67, v45
    v_dot2c_f32_bf16 v7, v45, v45
    v_dot2c_f32_bf16 v4, s67, v46
    v_dot2c_f32_bf16 v6, v46, v46
    v_dot2c_f32_bf16 v5, s67, v47
    v_dot2c_f32_bf16 v7, v47, v47
    s_barrier
    ds_read_b64 v[94:95], v97 offset:640
    s_waitcnt lgkmcnt(0)
    v_readfirstlane_b32 s52, v94
    v_readfirstlane_b32 s53, v95
    v_lshlrev_b32 v8, 16, v16
    v_and_b32 v9, 0xffff0000, v16
    v_lshlrev_b32 v10, 16, v17
    v_and_b32 v11, 0xffff0000, v17
    v_lshlrev_b32 v12, 16, v18
    v_and_b32 v13, 0xffff0000, v18
    v_lshlrev_b32 v14, 16, v19
    v_and_b32 v15, 0xffff0000, v19
    v_pk_fma_f32 v[8:9], v[8:9], s[52:53], s[52:53] op_sel:[0,0,1] op_sel_hi:[1,0,1]
    v_pk_fma_f32 v[10:11], v[10:11], s[52:53], s[52:53] op_sel:[0,0,1] op_sel_hi:[1,0,1]
    v_pk_fma_f32 v[12:13], v[12:13], s[52:53], s[52:53] op_sel:[0,0,1] op_sel_hi:[1,0,1]
    v_pk_fma_f32 v[14:15], v[14:15], s[52:53], s[52:53] op_sel:[0,0,1] op_sel_hi:[1,0,1]
    v_cvt_pk_bf16_f32 v16, v8, v9
    v_cvt_pk_bf16_f32 v17, v10, v11
    v_cvt_pk_bf16_f32 v18, v12, v13
    v_cvt_pk_bf16_f32 v19, v14, v15
    buffer_store_dwordx4 v[16:19], v2, s[20:23], s24 offen sc0 sc1
    s_waitcnt vmcnt(2)
    v_dot2c_f32_bf16 v4, s67, v48
    v_dot2c_f32_bf16 v6, v48, v48
    v_dot2c_f32_bf16 v5, s67, v49
    v_dot2c_f32_bf16 v7, v49, v49
    v_dot2c_f32_bf16 v4, s67, v50
    v_dot2c_f32_bf16 v6, v50, v50
    v_dot2c_f32_bf16 v5, s67, v51
    v_dot2c_f32_bf16 v7, v51, v51
    s_barrier
    buffer_load_dwordx4 v[56:59], v1, s[16:19], s34 offen nt
    s_waitcnt vmcnt(2)
    v_dot2c_f32_bf16 v4, s67, v52
    v_dot2c_f32_bf16 v6, v52, v52
    v_dot2c_f32_bf16 v5, s67, v53
    v_dot2c_f32_bf16 v7, v53, v53
    v_dot2c_f32_bf16 v4, s67, v54
    v_dot2c_f32_bf16 v6, v54, v54
    v_dot2c_f32_bf16 v5, s67, v55
    v_dot2c_f32_bf16 v7, v55, v55
    s_nop 2
    v_add_f32 v4, v4, v5
    v_add_f32 v6, v6, v7
    v_mul_f32 v5, 0x3d000000, v4
    v_fma_f32 v6, -v4, v5, v6
    v_sub_f32 v4, v5, v89
    v_mul_f32 v5, 0x42000000, v4
    v_fma_f32 v5, v5, v4, v6
    s_nop 1
    v_permlane32_swap_b32 v4, v5
    s_nop 1
    v_add_f32 v4, v4, v5
    s_nop 1
    v_add_f32_dpp v4, v4, v4 quad_perm:[1,0,3,2] row_mask:0xf bank_mask:0xf
    s_nop 1
    v_add_f32_dpp v4, v4, v4 quad_perm:[2,3,0,1] row_mask:0xf bank_mask:0xf
    s_nop 1
    v_add_f32_dpp v4, v4, v4 row_half_mirror row_mask:0xf bank_mask:0xf
    s_nop 1
    v_add_f32_dpp v4, v4, v4 row_mirror row_mask:0xf bank_mask:0xf
    s_nop 1
    v_add_f32_dpp v4, v4, v4 row_bcast:15 row_mask:0xa bank_mask:0xf
    s_mov_b32 exec_lo, 0x80000000
    s_mov_b32 exec_hi, 0x80000000
    ds_write_b32 v3, v4 offset:256
    s_mov_b64 exec, -1
    v_lshlrev_b32 v8, 16, v20
    v_and_b32 v9, 0xffff0000, v20
    v_lshlrev_b32 v10, 16, v21
    v_and_b32 v11, 0xffff0000, v21
    v_lshlrev_b32 v12, 16, v22
    v_and_b32 v13, 0xffff0000, v22
    v_lshlrev_b32 v14, 16, v23
    v_and_b32 v15, 0xffff0000, v23
    v_pk_fma_f32 v[8:9], v[8:9], s[52:53], s[52:53] op_sel:[0,0,1] op_sel_hi:[1,0,1]
    v_pk_fma_f32 v[10:11], v[10:11], s[52:53], s[52:53] op_sel:[0,0,1] op_sel_hi:[1,0,1]
    v_pk_fma_f32 v[12:13], v[12:13], s[52:53], s[52:53] op_sel:[0,0,1] op_sel_hi:[1,0,1]
    v_pk_fma_f32 v[14:15], v[14:15], s[52:53], s[52:53] op_sel:[0,0,1] op_sel_hi:[1,0,1]
    v_cvt_pk_bf16_f32 v20, v8, v9
    v_cvt_pk_bf16_f32 v21, v10, v11
    v_cvt_pk_bf16_f32 v22, v12, v13
    v_cvt_pk_bf16_f32 v23, v14, v15
    s_waitcnt lgkmcnt(0)
    s_barrier
    buffer_store_dwordx4 v[20:23], v2, s[20:23], s25 offen sc0 sc1
    s_cmp_lg_u32 s15, 0
    s_cbranch_scc1 L_nl14
    s_mov_b32 s93, s51
    s_mov_b32 s95, s51
    v_and_b32 v94, 15, v0
    v_bfe_u32 v95, v0, 4, 1
    v_lshlrev_b32 v94, 3, v94
    v_lshl_add_u32 v94, v95, 2, v94
    ds_read_b32 v94, v94 offset:256
    s_waitcnt lgkmcnt(0)
    v_add_f32_dpp v94, v94, v94 quad_perm:[1,0,3,2] row_mask:0xf bank_mask:0xf
    s_nop 1
    v_add_f32_dpp v94, v94, v94 quad_perm:[2,3,0,1] row_mask:0xf bank_mask:0xf
    s_nop 1
    v_add_f32_dpp v94, v94, v94 row_half_mirror row_mask:0xf bank_mask:0xf
    s_nop 1
    v_add_f32_dpp v94, v94, v94 row_mirror row_mask:0xf bank_mask:0xf
    s_nop 1
    v_readlane_b32 s94, v94, 16
    v_mov_b32 v12, v94
    v_mov_b32 v13, s93
    v_mov_b32 v15, s95
    v_mov_b32 v95, s57
    v_mov_b32 v14, s94
    s_mov_b64 exec, 1
    global_store_dwordx4 v95, v[12:15], s[12:13] offset:640 sc0 sc1
    s_mov_b64 exec, -1
    s_nop 0
L_nl14:
    s_barrier
    s_cmp_lg_u32 s15, 1
    s_cbranch_scc1 L_pi15
    s_load_dwordx4 s[76:79], s[12:13], s65 offset:512 glc
L_pi15:
    buffer_load_dwordx4 v[60:63], v1, s[16:19], s35 offen nt
    s_cmp_lg_u32 s15, 1
    s_cbranch_scc1 L_go16
    ds_read_b32 v98, v97 offset:724
    ds_read_b32 v99, v97 offset:728
    v_and_b32 v8, 15, v0
    v_bfe_u32 v9, v0, 4, 1
    v_lshlrev_b32 v8, 3, v8
    v_lshl_add_u32 v8, v9, 2, v8
    ds_read_b32 v8, v8 offset:128
    s_waitcnt lgkmcnt(0)
    v_add_f32_dpp v8, v8, v8 quad_perm:[1,0,3,2] row_mask:0xf bank_mask:0xf
    s_nop 1
    v_add_f32_dpp v8, v8, v8 quad_perm:[2,3,0,1] row_mask:0xf bank_mask:0xf
    s_nop 1
    v_add_f32_dpp v8, v8, v8 row_half_mirror row_mask:0xf bank_mask:0xf
    s_nop 1
    v_add_f32_dpp v8, v8, v8 row_mirror row_mask:0xf bank_mask:0xf
    s_nop 1
    v_readlane_b32 s84, v8, 0
    v_readlane_b32 s85, v8, 16
    s_branch L_ck19
L_cp17:
    s_add_u32 s68, s68, 1
    s_cmp_gt_u32 s68, 1000000
    s_cbranch_scc1 L_cd18
    s_load_dwordx4 s[76:79], s[12:13], s65 offset:512 glc
L_ck19:
    s_waitcnt lgkmcnt(0)
    s_cmp_lg_u32 s77, s51
    s_cbranch_scc1 L_cp17
    s_cmp_lg_u32 s79, s51
    s_cbranch_scc1 L_cp17
L_cd18:
    v_mov_b32 v94, s76
    v_mov_b32 v95, s78
    v_add_f32 v94, s84, v94
    v_add_f32 v95, s85, v95
    v_mul_f32 v94, 0x3a000000, v94
    v_mul_f32 v95, 0x37800000, v95
    v_fma_f32 v95, -v94, v94, v95
    v_max_f32 v95, 0, v95
    v_add_f32 v94, v88, v94
    v_cvt_pk_bf16_f32 v8, v94, v94
    v_and_b32 v8, 0xffff0000, v8
    v_sub_f32 v94, v94, v8
    v_fma_f32 v95, v94, v94, v95
    v_cvt_pk_bf16_f32 v95, v95, v95
    v_and_b32 v95, 0xffff0000, v95
    v_add_f32 v95, 0x3727c5ac, v95
    v_cvt_pk_bf16_f32 v95, v95, v95
    v_and_b32 v95, 0xffff0000, v95
    v_sqrt_f32 v95, v95
    s_nop 0
    v_cvt_pk_bf16_f32 v95, v95, v95
    v_and_b32 v95, 0xffff0000, v95
    v_rcp_f32 v95, v95
    s_nop 0
    v_mul_f32 v94, v98, v95
    v_fma_f32 v95, -v8, v94, v99
    s_mov_b64 exec, 1
    ds_write_b64 v97, v[94:95] offset:656
    s_mov_b64 exec, -1
    s_waitcnt lgkmcnt(0)
L_go16:
    s_waitcnt vmcnt(2)
    v_dot2_f32_bf16 v4, v56, s67, 0
    v_dot2_f32_bf16 v6, v56, v56, 0
    v_dot2_f32_bf16 v5, v57, s67, 0
    v_dot2_f32_bf16 v7, v57, v57, 0
    s_nop 1
    v_dot2c_f32_bf16 v4, s67, v58
    v_dot2c_f32_bf16 v6, v58, v58
    v_dot2c_f32_bf16 v5, s67, v59
    v_dot2c_f32_bf16 v7, v59, v59
    s_barrier
    ds_read_b64 v[94:95], v97 offset:656
    s_waitcnt lgkmcnt(0)
    v_readfirstlane_b32 s52, v94
    v_readfirstlane_b32 s53, v95
    v_lshlrev_b32 v8, 16, v24
    v_and_b32 v9, 0xffff0000, v24
    v_lshlrev_b32 v10, 16, v25
    v_and_b32 v11, 0xffff0000, v25
    v_lshlrev_b32 v12, 16, v26
    v_and_b32 v13, 0xffff0000, v26
    v_lshlrev_b32 v14, 16, v27
    v_and_b32 v15, 0xffff0000, v27
    v_pk_fma_f32 v[8:9], v[8:9], s[52:53], s[52:53] op_sel:[0,0,1] op_sel_hi:[1,0,1]
    v_pk_fma_f32 v[10:11], v[10:11], s[52:53], s[52:53] op_sel:[0,0,1] op_sel_hi:[1,0,1]
    v_pk_fma_f32 v[12:13], v[12:13], s[52:53], s[52:53] op_sel:[0,0,1] op_sel_hi:[1,0,1]
    v_pk_fma_f32 v[14:15], v[14:15], s[52:53], s[52:53] op_sel:[0,0,1] op_sel_hi:[1,0,1]
    v_cvt_pk_bf16_f32 v24, v8, v9
    v_cvt_pk_bf16_f32 v25, v10, v11
    v_cvt_pk_bf16_f32 v26, v12, v13
    v_cvt_pk_bf16_f32 v27, v14, v15
    buffer_store_dwordx4 v[24:27], v101, s[20:23], s26 offen sc0 sc1
    s_barrier
    buffer_load_dwordx4 v[64:67], v1, s[16:19], s36 offen nt
    s_cmp_lg_u32 s15, 3
    s_cbranch_scc1 L_rf21
    s_getpc_b64 s[96:97]
L_rf21_pc:
    v_and_b32 v94, 63, v0
    v_lshlrev_b32 v94, 7, v94
    v_min_u32 v94, L_end - L_rf21_pc, v94
    global_load_dword v100, v94, s[96:97]
L_rf21:
    s_waitcnt vmcnt(2)
    v_dot2c_f32_bf16 v4, s67, v60
    v_dot2c_f32_bf16 v6, v60, v60
    v_dot2c_f32_bf16 v5, s67, v61
    v_dot2c_f32_bf16 v7, v61, v61
    v_dot2c_f32_bf16 v4, s67, v62
    v_dot2c_f32_bf16 v6, v62, v62
    v_dot2c_f32_bf16 v5, s67, v63
    v_dot2c_f32_bf16 v7, v63, v63
    v_lshlrev_b32 v8, 16, v28
    v_and_b32 v9, 0xffff0000, v28
    v_lshlrev_b32 v10, 16, v29
    v_and_b32 v11, 0xffff0000, v29
    v_lshlrev_b32 v12, 16, v30
    v_and_b32 v13, 0xffff0000, v30
    v_lshlrev_b32 v14, 16, v31
    v_and_b32 v15, 0xffff0000, v31
    v_pk_fma_f32 v[8:9], v[8:9], s[52:53], s[52:53] op_sel:[0,0,1] op_sel_hi:[1,0,1]
    v_pk_fma_f32 v[10:11], v[10:11], s[52:53], s[52:53] op_sel:[0,0,1] op_sel_hi:[1,0,1]
    v_pk_fma_f32 v[12:13], v[12:13], s[52:53], s[52:53] op_sel:[0,0,1] op_sel_hi:[1,0,1]
    v_pk_fma_f32 v[14:15], v[14:15], s[52:53], s[52:53] op_sel:[0,0,1] op_sel_hi:[1,0,1]
    v_cvt_pk_bf16_f32 v28, v8, v9
    v_cvt_pk_bf16_f32 v29, v10, v11
    v_cvt_pk_bf16_f32 v30, v12, v13
    v_cvt_pk_bf16_f32 v31, v14, v15
    s_barrier
    buffer_store_dwordx4 v[28:31], v101, s[20:23], s27 offen sc0 sc1
    s_barrier
    buffer_load_dwordx4 v[68:71], v1, s[16:19], s37 offen nt
    s_waitcnt vmcnt(2)
    v_dot2c_f32_bf16 v4, s67, v64
    v_dot2c_f32_bf16 v6, v64, v64
    v_dot2c_f32_bf16 v5, s67, v65
    v_dot2c_f32_bf16 v7, v65, v65
    v_dot2c_f32_bf16 v4, s67, v66
    v_dot2c_f32_bf16 v6, v66, v66
    v_dot2c_f32_bf16 v5, s67, v67
    v_dot2c_f32_bf16 v7, v67, v67
    v_lshlrev_b32 v8, 16, v32
    v_and_b32 v9, 0xffff0000, v32
    v_lshlrev_b32 v10, 16, v33
    v_and_b32 v11, 0xffff0000, v33
    v_lshlrev_b32 v12, 16, v34
    v_and_b32 v13, 0xffff0000, v34
    v_lshlrev_b32 v14, 16, v35
    v_and_b32 v15, 0xffff0000, v35
    v_pk_fma_f32 v[8:9], v[8:9], s[52:53], s[52:53] op_sel:[0,0,1] op_sel_hi:[1,0,1]
    v_pk_fma_f32 v[10:11], v[10:11], s[52:53], s[52:53] op_sel:[0,0,1] op_sel_hi:[1,0,1]
    v_pk_fma_f32 v[12:13], v[12:13], s[52:53], s[52:53] op_sel:[0,0,1] op_sel_hi:[1,0,1]
    v_pk_fma_f32 v[14:15], v[14:15], s[52:53], s[52:53] op_sel:[0,0,1] op_sel_hi:[1,0,1]
    v_cvt_pk_bf16_f32 v32, v8, v9
    v_cvt_pk_bf16_f32 v33, v10, v11
    v_cvt_pk_bf16_f32 v34, v12, v13
    v_cvt_pk_bf16_f32 v35, v14, v15
    s_barrier
    buffer_store_dwordx4 v[32:35], v101, s[20:23], s28 offen sc0 sc1
    s_barrier
    buffer_load_dwordx4 v[72:75], v101, s[16:19], s38 offen nt
    s_waitcnt vmcnt(2)
    v_dot2c_f32_bf16 v4, s67, v68
    v_dot2c_f32_bf16 v6, v68, v68
    v_dot2c_f32_bf16 v5, s67, v69
    v_dot2c_f32_bf16 v7, v69, v69
    v_dot2c_f32_bf16 v4, s67, v70
    v_dot2c_f32_bf16 v6, v70, v70
    v_dot2c_f32_bf16 v5, s67, v71
    v_dot2c_f32_bf16 v7, v71, v71
    s_nop 2
    v_add_f32 v4, v4, v5
    v_add_f32 v6, v6, v7
    v_mul_f32 v5, 0x3d000000, v4
    v_fma_f32 v6, -v4, v5, v6
    v_sub_f32 v4, v5, v90
    v_mul_f32 v5, 0x42000000, v4
    v_fma_f32 v5, v5, v4, v6
    s_nop 1
    v_permlane32_swap_b32 v4, v5
    s_nop 1
    v_add_f32 v4, v4, v5
    s_nop 1
    v_add_f32_dpp v4, v4, v4 quad_perm:[1,0,3,2] row_mask:0xf bank_mask:0xf
    s_nop 1
    v_add_f32_dpp v4, v4, v4 quad_perm:[2,3,0,1] row_mask:0xf bank_mask:0xf
    s_nop 1
    v_add_f32_dpp v4, v4, v4 row_half_mirror row_mask:0xf bank_mask:0xf
    s_nop 1
    v_add_f32_dpp v4, v4, v4 row_mirror row_mask:0xf bank_mask:0xf
    s_nop 1
    v_add_f32_dpp v4, v4, v4 row_bcast:15 row_mask:0xa bank_mask:0xf
    s_mov_b32 exec_lo, 0x80000000
    s_mov_b32 exec_hi, 0x80000000
    ds_write_b32 v3, v4 offset:384
    s_mov_b64 exec, -1
    v_lshlrev_b32 v8, 16, v36
    v_and_b32 v9, 0xffff0000, v36
    v_lshlrev_b32 v10, 16, v37
    v_and_b32 v11, 0xffff0000, v37
    v_lshlrev_b32 v12, 16, v38
    v_and_b32 v13, 0xffff0000, v38
    v_lshlrev_b32 v14, 16, v39
    v_and_b32 v15, 0xffff0000, v39
    v_pk_fma_f32 v[8:9], v[8:9], s[52:53], s[52:53] op_sel:[0,0,1] op_sel_hi:[1,0,1]
    v_pk_fma_f32 v[10:11], v[10:11], s[52:53], s[52:53] op_sel:[0,0,1] op_sel_hi:[1,0,1]
    v_pk_fma_f32 v[12:13], v[12:13], s[52:53], s[52:53] op_sel:[0,0,1] op_sel_hi:[1,0,1]
    v_pk_fma_f32 v[14:15], v[14:15], s[52:53], s[52:53] op_sel:[0,0,1] op_sel_hi:[1,0,1]
    v_cvt_pk_bf16_f32 v36, v8, v9
    v_cvt_pk_bf16_f32 v37, v10, v11
    v_cvt_pk_bf16_f32 v38, v12, v13
    v_cvt_pk_bf16_f32 v39, v14, v15
    s_waitcnt lgkmcnt(0)
    s_barrier
    buffer_store_dwordx4 v[36:39], v101, s[20:23], s29 offen sc0 sc1
    s_cmp_lg_u32 s15, 2
    s_cbranch_scc1 L_nl22
    s_mov_b32 s93, s51
    s_mov_b32 s95, s51
    v_and_b32 v94, 15, v0
    v_bfe_u32 v95, v0, 4, 1
    v_lshlrev_b32 v94, 3, v94
    v_lshl_add_u32 v94, v95, 2, v94
    ds_read_b32 v94, v94 offset:384
    s_waitcnt lgkmcnt(0)
    v_add_f32_dpp v94, v94, v94 quad_perm:[1,0,3,2] row_mask:0xf bank_mask:0xf
    s_nop 1
    v_add_f32_dpp v94, v94, v94 quad_perm:[2,3,0,1] row_mask:0xf bank_mask:0xf
    s_nop 1
    v_add_f32_dpp v94, v94, v94 row_half_mirror row_mask:0xf bank_mask:0xf
    s_nop 1
    v_add_f32_dpp v94, v94, v94 row_mirror row_mask:0xf bank_mask:0xf
    s_nop 1
    v_readlane_b32 s94, v94, 16
    v_mov_b32 v12, v94
    v_mov_b32 v13, s93
    v_mov_b32 v15, s95
    v_mov_b32 v95, s57
    v_mov_b32 v14, s94
    s_mov_b64 exec, 1
    global_store_dwordx4 v95, v[12:15], s[12:13] offset:768 sc0 sc1
    s_mov_b64 exec, -1
    s_nop 0
    s_and_b32 s48, s2, 7
    s_cbranch_scc1 L_nl22
    v_mov_b32 v94, 1
    s_mov_b64 exec, 1
    global_atomic_add v97, v94, s[12:13] offset:192
    s_mov_b64 exec, -1
L_nl22:
    s_barrier
    s_cmp_lg_u32 s15, 1
    s_cbranch_scc1 L_pi23
    s_load_dwordx4 s[76:79], s[12:13], s65 offset:640 glc
L_pi23:
    buffer_load_dwordx4 v[76:79], v101, s[16:19], s39 offen nt
    s_cmp_lg_u32 s15, 1
    s_cbranch_scc1 L_go24
    ds_read_b32 v98, v97 offset:740
    ds_read_b32 v99, v97 offset:744
    v_and_b32 v8, 15, v0
    v_bfe_u32 v9, v0, 4, 1
    v_lshlrev_b32 v8, 3, v8
    v_lshl_add_u32 v8, v9, 2, v8
    ds_read_b32 v8, v8 offset:256
    s_waitcnt lgkmcnt(0)
    v_add_f32_dpp v8, v8, v8 quad_perm:[1,0,3,2] row_mask:0xf bank_mask:0xf
    s_nop 1
    v_add_f32_dpp v8, v8, v8 quad_perm:[2,3,0,1] row_mask:0xf bank_mask:0xf
    s_nop 1
    v_add_f32_dpp v8, v8, v8 row_half_mirror row_mask:0xf bank_mask:0xf
    s_nop 1
    v_add_f32_dpp v8, v8, v8 row_mirror row_mask:0xf bank_mask:0xf
    s_nop 1
    v_readlane_b32 s84, v8, 0
    v_readlane_b32 s85, v8, 16
    s_branch L_ck27
L_cp25:
    s_add_u32 s68, s68, 1
    s_cmp_gt_u32 s68, 1000000
    s_cbranch_scc1 L_cd26
    s_load_dwordx4 s[76:79], s[12:13], s65 offset:640 glc
L_ck27:
    s_waitcnt lgkmcnt(0)
    s_cmp_lg_u32 s77, s51
    s_cbranch_scc1 L_cp25
    s_cmp_lg_u32 s79, s51
    s_cbranch_scc1 L_cp25
L_cd26:
    v_mov_b32 v94, s76
    v_mov_b32 v95, s78
    v_add_f32 v94, s84, v94
    v_add_f32 v95, s85, v95
    v_mul_f32 v94, 0x3a000000, v94
    v_mul_f32 v95, 0x37800000, v95
    v_fma_f32 v95, -v94, v94, v95
    v_max_f32 v95, 0, v95
    v_add_f32 v94, v89, v94
    v_cvt_pk_bf16_f32 v8, v94, v94
    v_and_b32 v8, 0xffff0000, v8
    v_sub_f32 v94, v94, v8
    v_fma_f32 v95, v94, v94, v95
    v_cvt_pk_bf16_f32 v95, v95, v95
    v_and_b32 v95, 0xffff0000, v95
    v_add_f32 v95, 0x3727c5ac, v95
    v_cvt_pk_bf16_f32 v95, v95, v95
    v_and_b32 v95, 0xffff0000, v95
    v_sqrt_f32 v95, v95
    s_nop 0
    v_cvt_pk_bf16_f32 v95, v95, v95
    v_and_b32 v95, 0xffff0000, v95
    v_rcp_f32 v95, v95
    s_nop 0
    v_mul_f32 v94, v98, v95
    v_fma_f32 v95, -v8, v94, v99
    s_mov_b64 exec, 1
    ds_write_b64 v97, v[94:95] offset:672
    s_mov_b64 exec, -1
    s_waitcnt lgkmcnt(0)
L_go24:
    s_waitcnt vmcnt(2)
    v_dot2_f32_bf16 v4, v72, s67, 0
    v_dot2_f32_bf16 v6, v72, v72, 0
    v_dot2_f32_bf16 v5, v73, s67, 0
    v_dot2_f32_bf16 v7, v73, v73, 0
    s_nop 1
    v_dot2c_f32_bf16 v4, s67, v74
    v_dot2c_f32_bf16 v6, v74, v74
    v_dot2c_f32_bf16 v5, s67, v75
    v_dot2c_f32_bf16 v7, v75, v75
    s_barrier
    ds_read_b64 v[94:95], v97 offset:672
    s_waitcnt lgkmcnt(0)
    v_readfirstlane_b32 s52, v94
    v_readfirstlane_b32 s53, v95
    v_lshlrev_b32 v8, 16, v40
    v_and_b32 v9, 0xffff0000, v40
    v_lshlrev_b32 v10, 16, v41
    v_and_b32 v11, 0xffff0000, v41
    v_lshlrev_b32 v12, 16, v42
    v_and_b32 v13, 0xffff0000, v42
    v_lshlrev_b32 v14, 16, v43
    v_and_b32 v15, 0xffff0000, v43
    v_pk_fma_f32 v[8:9], v[8:9], s[52:53], s[52:53] op_sel:[0,0,1] op_sel_hi:[1,0,1]
    v_pk_fma_f32 v[10:11], v[10:11], s[52:53], s[52:53] op_sel:[0,0,1] op_sel_hi:[1,0,1]
    v_pk_fma_f32 v[12:13], v[12:13], s[52:53], s[52:53] op_sel:[0,0,1] op_sel_hi:[1,0,1]
    v_pk_fma_f32 v[14:15], v[14:15], s[52:53], s[52:53] op_sel:[0,0,1] op_sel_hi:[1,0,1]
    v_cvt_pk_bf16_f32 v40, v8, v9
    v_cvt_pk_bf16_f32 v41, v10, v11
    v_cvt_pk_bf16_f32 v42, v12, v13
    v_cvt_pk_bf16_f32 v43, v14, v15
    buffer_store_dwordx4 v[40:43], v101, s[20:23], s30 offen sc0 sc1
    s_barrier
    buffer_load_dwordx4 v[80:83], v101, s[16:19], s40 offen nt
    s_waitcnt vmcnt(2)
    v_dot2c_f32_bf16 v4, s67, v76
    v_dot2c_f32_bf16 v6, v76, v76
    v_dot2c_f32_bf16 v5, s67, v77
    v_dot2c_f32_bf16 v7, v77, v77
    v_dot2c_f32_bf16 v4, s67, v78
    v_dot2c_f32_bf16 v6, v78, v78
    v_dot2c_f32_bf16 v5, s67, v79
    v_dot2c_f32_bf16 v7, v79, v79
    v_lshlrev_b32 v8, 16, v44
    v_and_b32 v9, 0xffff0000, v44
    v_lshlrev_b32 v10, 16, v45
    v_and_b32 v11, 0xffff0000, v45
    v_lshlrev_b32 v12, 16, v46
    v_and_b32 v13, 0xffff0000, v46
    v_lshlrev_b32 v14, 16, v47
    v_and_b32 v15, 0xffff0000, v47
    v_pk_fma_f32 v[8:9], v[8:9], s[52:53], s[52:53] op_sel:[0,0,1] op_sel_hi:[1,0,1]
    v_pk_fma_f32 v[10:11], v[10:11], s[52:53], s[52:53] op_sel:[0,0,1] op_sel_hi:[1,0,1]
    v_pk_fma_f32 v[12:13], v[12:13], s[52:53], s[52:53] op_sel:[0,0,1] op_sel_hi:[1,0,1]
    v_pk_fma_f32 v[14:15], v[14:15], s[52:53], s[52:53] op_sel:[0,0,1] op_sel_hi:[1,0,1]
    v_cvt_pk_bf16_f32 v44, v8, v9
    v_cvt_pk_bf16_f32 v45, v10, v11
    v_cvt_pk_bf16_f32 v46, v12, v13
    v_cvt_pk_bf16_f32 v47, v14, v15
    s_barrier
    buffer_store_dwordx4 v[44:47], v101, s[20:23], s31 offen sc0 sc1
    v_lshlrev_b32 v8, 16, v48
    v_and_b32 v9, 0xffff0000, v48
    v_lshlrev_b32 v10, 16, v49
    v_and_b32 v11, 0xffff0000, v49
    v_lshlrev_b32 v12, 16, v50
    v_and_b32 v13, 0xffff0000, v50
    v_lshlrev_b32 v14, 16, v51
    v_and_b32 v15, 0xffff0000, v51
    v_pk_fma_f32 v[8:9], v[8:9], s[52:53], s[52:53] op_sel:[0,0,1] op_sel_hi:[1,0,1]
    v_pk_fma_f32 v[10:11], v[10:11], s[52:53], s[52:53] op_sel:[0,0,1] op_sel_hi:[1,0,1]
    v_pk_fma_f32 v[12:13], v[12:13], s[52:53], s[52:53] op_sel:[0,0,1] op_sel_hi:[1,0,1]
    v_pk_fma_f32 v[14:15], v[14:15], s[52:53], s[52:53] op_sel:[0,0,1] op_sel_hi:[1,0,1]
    v_cvt_pk_bf16_f32 v48, v8, v9
    v_cvt_pk_bf16_f32 v49, v10, v11
    v_cvt_pk_bf16_f32 v50, v12, v13
    v_cvt_pk_bf16_f32 v51, v14, v15
    s_barrier
    buffer_store_dwordx4 v[48:51], v101, s[20:23], s32 offen sc0 sc1
    s_waitcnt vmcnt(2)
    v_dot2c_f32_bf16 v4, s67, v80
    v_dot2c_f32_bf16 v6, v80, v80
    v_dot2c_f32_bf16 v5, s67, v81
    v_dot2c_f32_bf16 v7, v81, v81
    v_dot2c_f32_bf16 v4, s67, v82
    v_dot2c_f32_bf16 v6, v82, v82
    v_dot2c_f32_bf16 v5, s67, v83
    v_dot2c_f32_bf16 v7, v83, v83
    s_barrier
    s_cmp_lg_u32 s15, 1
    s_cbranch_scc1 L_pi29
    s_load_dwordx4 s[76:79], s[12:13], s65 offset:768 glc
L_pi29:
    buffer_load_dwordx4 v[84:87], v101, s[16:19], s41 offen nt
    s_cmp_lg_u32 s15, 1
    s_cbranch_scc1 L_go30
    ds_read_b32 v98, v97 offset:756
    ds_read_b32 v99, v97 offset:760
    v_and_b32 v8, 15, v0
    v_bfe_u32 v9, v0, 4, 1
    v_lshlrev_b32 v8, 3, v8
    v_lshl_add_u32 v8, v9, 2, v8
    ds_read_b32 v8, v8 offset:384
    s_waitcnt lgkmcnt(0)
    v_add_f32_dpp v8, v8, v8 quad_perm:[1,0,3,2] row_mask:0xf bank_mask:0xf
    s_nop 1
    v_add_f32_dpp v8, v8, v8 quad_perm:[2,3,0,1] row_mask:0xf bank_mask:0xf
    s_nop 1
    v_add_f32_dpp v8, v8, v8 row_half_mirror row_mask:0xf bank_mask:0xf
    s_nop 1
    v_add_f32_dpp v8, v8, v8 row_mirror row_mask:0xf bank_mask:0xf
    s_nop 1
    v_readlane_b32 s84, v8, 0
    v_readlane_b32 s85, v8, 16
    s_branch L_ck33
L_cp31:
    s_add_u32 s68, s68, 1
    s_cmp_gt_u32 s68, 1000000
    s_cbranch_scc1 L_cd32
    s_load_dwordx4 s[76:79], s[12:13], s65 offset:768 glc
L_ck33:
    s_waitcnt lgkmcnt(0)
    s_cmp_lg_u32 s77, s51
    s_cbranch_scc1 L_cp31
    s_cmp_lg_u32 s79, s51
    s_cbranch_scc1 L_cp31
L_cd32:
    v_mov_b32 v94, s76
    v_mov_b32 v95, s78
    v_add_f32 v94, s84, v94
    v_add_f32 v95, s85, v95
    v_mul_f32 v94, 0x3a000000, v94
    v_mul_f32 v95, 0x37800000, v95
    v_fma_f32 v95, -v94, v94, v95
    v_max_f32 v95, 0, v95
    v_add_f32 v94, v90, v94
    v_cvt_pk_bf16_f32 v8, v94, v94
    v_and_b32 v8, 0xffff0000, v8
    v_sub_f32 v94, v94, v8
    v_fma_f32 v95, v94, v94, v95
    v_cvt_pk_bf16_f32 v95, v95, v95
    v_and_b32 v95, 0xffff0000, v95
    v_add_f32 v95, 0x3727c5ac, v95
    v_cvt_pk_bf16_f32 v95, v95, v95
    v_and_b32 v95, 0xffff0000, v95
    v_sqrt_f32 v95, v95
    s_nop 0
    v_cvt_pk_bf16_f32 v95, v95, v95
    v_and_b32 v95, 0xffff0000, v95
    v_rcp_f32 v95, v95
    s_nop 0
    v_mul_f32 v94, v98, v95
    v_fma_f32 v95, -v8, v94, v99
    s_mov_b64 exec, 1
    ds_write_b64 v97, v[94:95] offset:688
    s_mov_b64 exec, -1
    s_waitcnt lgkmcnt(0)
L_go30:
    v_lshlrev_b32 v8, 16, v52
    v_and_b32 v9, 0xffff0000, v52
    v_lshlrev_b32 v10, 16, v53
    v_and_b32 v11, 0xffff0000, v53
    v_lshlrev_b32 v12, 16, v54
    v_and_b32 v13, 0xffff0000, v54
    v_lshlrev_b32 v14, 16, v55
    v_and_b32 v15, 0xffff0000, v55
    v_pk_fma_f32 v[8:9], v[8:9], s[52:53], s[52:53] op_sel:[0,0,1] op_sel_hi:[1,0,1]
    v_pk_fma_f32 v[10:11], v[10:11], s[52:53], s[52:53] op_sel:[0,0,1] op_sel_hi:[1,0,1]
    v_pk_fma_f32 v[12:13], v[12:13], s[52:53], s[52:53] op_sel:[0,0,1] op_sel_hi:[1,0,1]
    v_pk_fma_f32 v[14:15], v[14:15], s[52:53], s[52:53] op_sel:[0,0,1] op_sel_hi:[1,0,1]
    v_cvt_pk_bf16_f32 v52, v8, v9
    v_cvt_pk_bf16_f32 v53, v10, v11
    v_cvt_pk_bf16_f32 v54, v12, v13
    v_cvt_pk_bf16_f32 v55, v14, v15
    s_barrier
    buffer_store_dwordx4 v[52:55], v101, s[20:23], s33 offen sc0 sc1
    ds_read_b64 v[94:95], v97 offset:688
    s_waitcnt lgkmcnt(0)
    v_readfirstlane_b32 s52, v94
    v_readfirstlane_b32 s53, v95
    v_lshlrev_b32 v8, 16, v56
    v_and_b32 v9, 0xffff0000, v56
    v_lshlrev_b32 v10, 16, v57
    v_and_b32 v11, 0xffff0000, v57
    v_lshlrev_b32 v12, 16, v58
    v_and_b32 v13, 0xffff0000, v58
    v_lshlrev_b32 v14, 16, v59
    v_and_b32 v15, 0xffff0000, v59
    v_pk_fma_f32 v[8:9], v[8:9], s[52:53], s[52:53] op_sel:[0,0,1] op_sel_hi:[1,0,1]
    v_pk_fma_f32 v[10:11], v[10:11], s[52:53], s[52:53] op_sel:[0,0,1] op_sel_hi:[1,0,1]
    v_pk_fma_f32 v[12:13], v[12:13], s[52:53], s[52:53] op_sel:[0,0,1] op_sel_hi:[1,0,1]
    v_pk_fma_f32 v[14:15], v[14:15], s[52:53], s[52:53] op_sel:[0,0,1] op_sel_hi:[1,0,1]
    v_cvt_pk_bf16_f32 v56, v8, v9
    v_cvt_pk_bf16_f32 v57, v10, v11
    v_cvt_pk_bf16_f32 v58, v12, v13
    v_cvt_pk_bf16_f32 v59, v14, v15
    v_lshlrev_b32 v8, 16, v60
    v_and_b32 v9, 0xffff0000, v60
    v_lshlrev_b32 v10, 16, v61
    v_and_b32 v11, 0xffff0000, v61
    v_lshlrev_b32 v12, 16, v62
    v_and_b32 v13, 0xffff0000, v62
    v_lshlrev_b32 v14, 16, v63
    v_and_b32 v15, 0xffff0000, v63
    v_pk_fma_f32 v[8:9], v[8:9], s[52:53], s[52:53] op_sel:[0,0,1] op_sel_hi:[1,0,1]
    v_pk_fma_f32 v[10:11], v[10:11], s[52:53], s[52:53] op_sel:[0,0,1] op_sel_hi:[1,0,1]
    v_pk_fma_f32 v[12:13], v[12:13], s[52:53], s[52:53] op_sel:[0,0,1] op_sel_hi:[1,0,1]
    v_pk_fma_f32 v[14:15], v[14:15], s[52:53], s[52:53] op_sel:[0,0,1] op_sel_hi:[1,0,1]
    v_cvt_pk_bf16_f32 v60, v8, v9
    v_cvt_pk_bf16_f32 v61, v10, v11
    v_cvt_pk_bf16_f32 v62, v12, v13
    v_cvt_pk_bf16_f32 v63, v14, v15
    v_lshlrev_b32 v8, 16, v64
    v_and_b32 v9, 0xffff0000, v64
    v_lshlrev_b32 v10, 16, v65
    v_and_b32 v11, 0xffff0000, v65
    v_lshlrev_b32 v12, 16, v66
    v_and_b32 v13, 0xffff0000, v66
    v_lshlrev_b32 v14, 16, v67
    v_and_b32 v15, 0xffff0000, v67
    v_pk_fma_f32 v[8:9], v[8:9], s[52:53], s[52:53] op_sel:[0,0,1] op_sel_hi:[1,0,1]
    v_pk_fma_f32 v[10:11], v[10:11], s[52:53], s[52:53] op_sel:[0,0,1] op_sel_hi:[1,0,1]
    v_pk_fma_f32 v[12:13], v[12:13], s[52:53], s[52:53] op_sel:[0,0,1] op_sel_hi:[1,0,1]
    v_pk_fma_f32 v[14:15], v[14:15], s[52:53], s[52:53] op_sel:[0,0,1] op_sel_hi:[1,0,1]
    v_cvt_pk_bf16_f32 v64, v8, v9
    v_cvt_pk_bf16_f32 v65, v10, v11
    v_cvt_pk_bf16_f32 v66, v12, v13
    v_cvt_pk_bf16_f32 v67, v14, v15
    v_lshlrev_b32 v8, 16, v68
    v_and_b32 v9, 0xffff0000, v68
    v_lshlrev_b32 v10, 16, v69
    v_and_b32 v11, 0xffff0000, v69
    v_lshlrev_b32 v12, 16, v70
    v_and_b32 v13, 0xffff0000, v70
    v_lshlrev_b32 v14, 16, v71
    v_and_b32 v15, 0xffff0000, v71
    v_pk_fma_f32 v[8:9], v[8:9], s[52:53], s[52:53] op_sel:[0,0,1] op_sel_hi:[1,0,1]
    v_pk_fma_f32 v[10:11], v[10:11], s[52:53], s[52:53] op_sel:[0,0,1] op_sel_hi:[1,0,1]
    v_pk_fma_f32 v[12:13], v[12:13], s[52:53], s[52:53] op_sel:[0,0,1] op_sel_hi:[1,0,1]
    v_pk_fma_f32 v[14:15], v[14:15], s[52:53], s[52:53] op_sel:[0,0,1] op_sel_hi:[1,0,1]
    v_cvt_pk_bf16_f32 v68, v8, v9
    v_cvt_pk_bf16_f32 v69, v10, v11
    v_cvt_pk_bf16_f32 v70, v12, v13
    v_cvt_pk_bf16_f32 v71, v14, v15
    s_barrier
    buffer_store_dwordx4 v[56:59], v1, s[20:23], s34 offen sc0 sc1
    s_waitcnt vmcnt(2)
    v_dot2c_f32_bf16 v4, s67, v84
    v_dot2c_f32_bf16 v6, v84, v84
    v_dot2c_f32_bf16 v5, s67, v85
    v_dot2c_f32_bf16 v7, v85, v85
    v_dot2c_f32_bf16 v4, s67, v86
    v_dot2c_f32_bf16 v6, v86, v86
    v_dot2c_f32_bf16 v5, s67, v87
    v_dot2c_f32_bf16 v7, v87, v87
    s_nop 2
    v_add_f32 v4, v4, v5
    v_add_f32 v6, v6, v7
    v_mul_f32 v5, 0x3d000000, v4
    v_fma_f32 v6, -v4, v5, v6
    v_sub_f32 v4, v5, v91
    v_mul_f32 v5, 0x42000000, v4
    v_fma_f32 v5, v5, v4, v6
    s_nop 1
    v_permlane32_swap_b32 v4, v5
    s_nop 1
    v_add_f32 v4, v4, v5
    s_nop 1
    v_add_f32_dpp v4, v4, v4 quad_perm:[1,0,3,2] row_mask:0xf bank_mask:0xf
    s_nop 1
    v_add_f32_dpp v4, v4, v4 quad_perm:[2,3,0,1] row_mask:0xf bank_mask:0xf
    s_nop 1
    v_add_f32_dpp v4, v4, v4 row_half_mirror row_mask:0xf bank_mask:0xf
    s_nop 1
    v_add_f32_dpp v4, v4, v4 row_mirror row_mask:0xf bank_mask:0xf
    s_nop 1
    v_add_f32_dpp v4, v4, v4 row_bcast:15 row_mask:0xa bank_mask:0xf
    s_mov_b32 exec_lo, 0x80000000
    s_mov_b32 exec_hi, 0x80000000
    ds_write_b32 v3, v4 offset:512
    s_mov_b64 exec, -1
    s_waitcnt lgkmcnt(0)
    s_barrier
    s_cmp_lg_u32 s15, 1
    s_cbranch_scc1 L_pi35
    s_load_dwordx4 s[76:79], s[12:13], s65 offset:896 glc
L_pi35:
    s_cmp_lg_u32 s15, 0
    s_cbranch_scc1 L_nl36
    s_mov_b32 s93, s51
    s_mov_b32 s95, s51
    v_and_b32 v94, 15, v0
    v_bfe_u32 v95, v0, 4, 1
    v_lshlrev_b32 v94, 3, v94
    v_lshl_add_u32 v94, v95, 2, v94
    ds_read_b32 v94, v94 offset:512
    s_waitcnt lgkmcnt(0)
    v_add_f32_dpp v94, v94, v94 quad_perm:[1,0,3,2] row_mask:0xf bank_mask:0xf
    s_nop 1
    v_add_f32_dpp v94, v94, v94 quad_perm:[2,3,0,1] row_mask:0xf bank_mask:0xf
    s_nop 1
    v_add_f32_dpp v94, v94, v94 row_half_mirror row_mask:0xf bank_mask:0xf
    s_nop 1
    v_add_f32_dpp v94, v94, v94 row_mirror row_mask:0xf bank_mask:0xf
    s_nop 1
    v_readlane_b32 s94, v94, 16
    v_mov_b32 v12, v94
    v_mov_b32 v13, s93
    v_mov_b32 v15, s95
    v_mov_b32 v95, s57
    v_mov_b32 v14, s94
    s_mov_b64 exec, 1
    global_store_dwordx4 v95, v[12:15], s[12:13] offset:896 sc0 sc1
    s_mov_b64 exec, -1
    s_nop 0
L_nl36:
    buffer_store_dwordx4 v[60:63], v1, s[20:23], s35 offen sc0 sc1
    buffer_store_dwordx4 v[64:67], v1, s[20:23], s36 offen sc0 sc1
    buffer_store_dwordx4 v[68:71], v1, s[20:23], s37 offen sc0 sc1
    s_cmp_lg_u32 s15, 1
    s_cbranch_scc1 L_go37
    ds_read_b32 v98, v97 offset:772
    ds_read_b32 v99, v97 offset:776
    v_and_b32 v8, 15, v0
    v_bfe_u32 v9, v0, 4, 1
    v_lshlrev_b32 v8, 3, v8
    v_lshl_add_u32 v8, v9, 2, v8
    ds_read_b32 v8, v8 offset:512
    s_waitcnt lgkmcnt(0)
    v_add_f32_dpp v8, v8, v8 quad_perm:[1,0,3,2] row_mask:0xf bank_mask:0xf
    s_nop 1
    v_add_f32_dpp v8, v8, v8 quad_perm:[2,3,0,1] row_mask:0xf bank_mask:0xf
    s_nop 1
    v_add_f32_dpp v8, v8, v8 row_half_mirror row_mask:0xf bank_mask:0xf
    s_nop 1
    v_add_f32_dpp v8, v8, v8 row_mirror row_mask:0xf bank_mask:0xf
    s_nop 1
    v_readlane_b32 s84, v8, 0
    v_readlane_b32 s85, v8, 16
    s_branch L_ck40
L_cp38:
    s_add_u32 s68, s68, 1
    s_cmp_gt_u32 s68, 1000000
    s_cbranch_scc1 L_cd39
    s_load_dwordx4 s[76:79], s[12:13], s65 offset:896 glc
L_ck40:
    s_waitcnt lgkmcnt(0)
    s_cmp_lg_u32 s77, s51
    s_cbranch_scc1 L_cp38
    s_cmp_lg_u32 s79, s51
    s_cbranch_scc1 L_cp38
L_cd39:
    v_mov_b32 v94, s76
    v_mov_b32 v95, s78
    v_add_f32 v94, s84, v94
    v_add_f32 v95, s85, v95
    v_mul_f32 v94, 0x3a000000, v94
    v_mul_f32 v95, 0x37800000, v95
    v_fma_f32 v95, -v94, v94, v95
    v_max_f32 v95, 0, v95
    v_add_f32 v94, v91, v94
    v_cvt_pk_bf16_f32 v8, v94, v94
    v_and_b32 v8, 0xffff0000, v8
    v_sub_f32 v94, v94, v8
    v_fma_f32 v95, v94, v94, v95
    v_cvt_pk_bf16_f32 v95, v95, v95
    v_and_b32 v95, 0xffff0000, v95
    v_add_f32 v95, 0x3727c5ac, v95
    v_cvt_pk_bf16_f32 v95, v95, v95
    v_and_b32 v95, 0xffff0000, v95
    v_sqrt_f32 v95, v95
    s_nop 0
    v_cvt_pk_bf16_f32 v95, v95, v95
    v_and_b32 v95, 0xffff0000, v95
    v_rcp_f32 v95, v95
    s_nop 0
    v_mul_f32 v94, v98, v95
    v_fma_f32 v95, -v8, v94, v99
    s_mov_b64 exec, 1
    ds_write_b64 v97, v[94:95] offset:704
    s_mov_b64 exec, -1
    s_waitcnt lgkmcnt(0)
L_go37:
    s_barrier
    ds_read_b64 v[94:95], v97 offset:704
    s_waitcnt lgkmcnt(0)
    v_readfirstlane_b32 s52, v94
    v_readfirstlane_b32 s53, v95
    v_lshlrev_b32 v8, 16, v72
    v_and_b32 v9, 0xffff0000, v72
    v_lshlrev_b32 v10, 16, v73
    v_and_b32 v11, 0xffff0000, v73
    v_lshlrev_b32 v12, 16, v74
    v_and_b32 v13, 0xffff0000, v74
    v_lshlrev_b32 v14, 16, v75
    v_and_b32 v15, 0xffff0000, v75
    v_pk_fma_f32 v[8:9], v[8:9], s[52:53], s[52:53] op_sel:[0,0,1] op_sel_hi:[1,0,1]
    v_pk_fma_f32 v[10:11], v[10:11], s[52:53], s[52:53] op_sel:[0,0,1] op_sel_hi:[1,0,1]
    v_pk_fma_f32 v[12:13], v[12:13], s[52:53], s[52:53] op_sel:[0,0,1] op_sel_hi:[1,0,1]
    v_pk_fma_f32 v[14:15], v[14:15], s[52:53], s[52:53] op_sel:[0,0,1] op_sel_hi:[1,0,1]
    v_cvt_pk_bf16_f32 v72, v8, v9
    v_cvt_pk_bf16_f32 v73, v10, v11
    v_cvt_pk_bf16_f32 v74, v12, v13
    v_cvt_pk_bf16_f32 v75, v14, v15
    buffer_store_dwordx4 v[72:75], v101, s[20:23], s38 offen sc0 sc1
    v_lshlrev_b32 v8, 16, v76
    v_and_b32 v9, 0xffff0000, v76
    v_lshlrev_b32 v10, 16, v77
    v_and_b32 v11, 0xffff0000, v77
    v_lshlrev_b32 v12, 16, v78
    v_and_b32 v13, 0xffff0000, v78
    v_lshlrev_b32 v14, 16, v79
    v_and_b32 v15, 0xffff0000, v79
    v_pk_fma_f32 v[8:9], v[8:9], s[52:53], s[52:53] op_sel:[0,0,1] op_sel_hi:[1,0,1]
    v_pk_fma_f32 v[10:11], v[10:11], s[52:53], s[52:53] op_sel:[0,0,1] op_sel_hi:[1,0,1]
    v_pk_fma_f32 v[12:13], v[12:13], s[52:53], s[52:53] op_sel:[0,0,1] op_sel_hi:[1,0,1]
    v_pk_fma_f32 v[14:15], v[14:15], s[52:53], s[52:53] op_sel:[0,0,1] op_sel_hi:[1,0,1]
    v_cvt_pk_bf16_f32 v76, v8, v9
    v_cvt_pk_bf16_f32 v77, v10, v11
    v_cvt_pk_bf16_f32 v78, v12, v13
    v_cvt_pk_bf16_f32 v79, v14, v15
    buffer_store_dwordx4 v[76:79], v101, s[20:23], s39 offen sc0 sc1
    v_lshlrev_b32 v8, 16, v80
    v_and_b32 v9, 0xffff0000, v80
    v_lshlrev_b32 v10, 16, v81
    v_and_b32 v11, 0xffff0000, v81
    v_lshlrev_b32 v12, 16, v82
    v_and_b32 v13, 0xffff0000, v82
    v_lshlrev_b32 v14, 16, v83
    v_and_b32 v15, 0xffff0000, v83
    v_pk_fma_f32 v[8:9], v[8:9], s[52:53], s[52:53] op_sel:[0,0,1] op_sel_hi:[1,0,1]
    v_pk_fma_f32 v[10:11], v[10:11], s[52:53], s[52:53] op_sel:[0,0,1] op_sel_hi:[1,0,1]
    v_pk_fma_f32 v[12:13], v[12:13], s[52:53], s[52:53] op_sel:[0,0,1] op_sel_hi:[1,0,1]
    v_pk_fma_f32 v[14:15], v[14:15], s[52:53], s[52:53] op_sel:[0,0,1] op_sel_hi:[1,0,1]
    v_cvt_pk_bf16_f32 v80, v8, v9
    v_cvt_pk_bf16_f32 v81, v10, v11
    v_cvt_pk_bf16_f32 v82, v12, v13
    v_cvt_pk_bf16_f32 v83, v14, v15
    buffer_store_dwordx4 v[80:83], v101, s[20:23], s40 offen sc0 sc1
    v_lshlrev_b32 v8, 16, v84
    v_and_b32 v9, 0xffff0000, v84
    v_lshlrev_b32 v10, 16, v85
    v_and_b32 v11, 0xffff0000, v85
    v_lshlrev_b32 v12, 16, v86
    v_and_b32 v13, 0xffff0000, v86
    v_lshlrev_b32 v14, 16, v87
    v_and_b32 v15, 0xffff0000, v87
    v_pk_fma_f32 v[8:9], v[8:9], s[52:53], s[52:53] op_sel:[0,0,1] op_sel_hi:[1,0,1]
    v_pk_fma_f32 v[10:11], v[10:11], s[52:53], s[52:53] op_sel:[0,0,1] op_sel_hi:[1,0,1]
    v_pk_fma_f32 v[12:13], v[12:13], s[52:53], s[52:53] op_sel:[0,0,1] op_sel_hi:[1,0,1]
    v_pk_fma_f32 v[14:15], v[14:15], s[52:53], s[52:53] op_sel:[0,0,1] op_sel_hi:[1,0,1]
    v_cvt_pk_bf16_f32 v84, v8, v9
    v_cvt_pk_bf16_f32 v85, v10, v11
    v_cvt_pk_bf16_f32 v86, v12, v13
    v_cvt_pk_bf16_f32 v87, v14, v15
    buffer_store_dwordx4 v[84:87], v101, s[20:23], s41 offen sc0 sc1
L_end:
    s_endpgm
.section .rodata,"a"
.p2align 6
.amdhsa_kernel standalone__instancenorm__prompt_kernel
  .amdhsa_next_free_vgpr 103
  .amdhsa_next_free_sgpr 102
  .amdhsa_accum_offset 104
  .amdhsa_group_segment_fixed_size 0
  .amdhsa_kernarg_size 48
  .amdhsa_user_sgpr_count 2
  .amdhsa_user_sgpr_kernarg_segment_ptr 1
  .amdhsa_system_sgpr_workgroup_id_x 1
  .amdhsa_float_denorm_mode_32 3
.end_amdhsa_kernel
```
